```python
import torch

def _softmax(x, axis=-1):
    return torch.softmax(x, dim=axis)
def _gelu(x):
    return torch.nn.functional.gelu(x, approximate="tanh")
def _silu(x):
    return torch.nn.functional.silu(x)
def _sigmoid(x):
    return torch.sigmoid(x)
def _layernorm(x, axis=-1, eps=1e-5):
    m = x.mean(dim=axis, keepdim=True)
    v = x.var(dim=axis, keepdim=True, unbiased=False)
    return (x - m) / torch.sqrt(v + eps)
def _scatter_add(tgt, idx, src, axis=0):
    return tgt.clone().index_add_(axis, idx, src)
def _segment_sum(src, seg, n):
    out = torch.zeros((n,) + src.shape[1:], dtype=src.dtype)
    return out.index_add_(0, seg, src)
def _pad(x, pw):
    flat = tuple(v for pair in reversed(pw) for v in pair)
    return torch.nn.functional.pad(x, flat)

kernel_name = 'standalone__kernel_systems_refs_featgraph__graph'

def setup_inputs():

    _w = (lambda a: (lambda t: t.to(torch.bfloat16) if t.is_floating_point() else t)(torch.as_tensor(a)))
    N, deg, D = 25000, 32, 64
    E = N * deg
    scale = D ** -0.5
    src = (lambda lo, hi, *s: torch.randint(lo, hi, s))(0, N, E).to(torch.int64)
    dst = (lambda lo, hi, *s: torch.randint(lo, hi, s))(0, N, E).to(torch.int64)
    return {
        "x": _w((lambda *s: torch.randn(*s, dtype=torch.bfloat16) * 0.8)(N, D)),
        "src": _w(src),
        "dst": _w(dst),
        "w_q": _w((lambda *s: torch.randn(*s, dtype=torch.bfloat16) * 0.8)(D, D) * scale),
        "w_v": _w((lambda *s: torch.randn(*s, dtype=torch.bfloat16) * 0.05)(D, D) * scale),
    }

def reference(x, src, dst, w_q, w_v):
    N, D = x.shape
    xs = x[src]
    xd = x[dst]
    q = xd @ w_q
    logits = torch.einsum('ed,ed->e', xs, q) * (float(D) ** -0.5)
    alpha = _sigmoid(logits)
    msg = alpha[:, None] * (xs @ w_v)
    return _segment_sum(msg, dst, N)
```

```asm
; @launch grid=(256,1,1) block=(1024,1,1) lds=163840
.amdgcn_target "amdgcn-amd-amdhsa--gfx950"
.text
.globl standalone__kernel_systems_refs_featgraph__graph_kernel
.p2align 8
.type standalone__kernel_systems_refs_featgraph__graph_kernel,@function
standalone__kernel_systems_refs_featgraph__graph_kernel:
    s_cmp_ge_u32 s2, 256
    s_cbranch_scc1 L_end
    s_load_dwordx16 s[4:19], s[0:1], 0
    s_and_b32 s84, s2, 7
    s_lshl_b32 s84, s84, 5
    s_lshr_b32 s2, s2, 3
    s_or_b32 s2, s2, s84
    s_getpc_b64 s[88:89]
I_pc:
    v_lshlrev_b32 v127, 7, v0
    v_cmp_gt_u32 vcc, A_full-I_pc, v127
    s_and_saveexec_b64 s[90:91], vcc
    s_cbranch_execz I_c
    global_load_dword v127, v127, s[88:89]
I_c:
    s_mov_b64 exec, -1
    s_mul_i32 s84, s2, 12500
    v_lshlrev_b32 v2, 2, v0
    v_lshrrev_b32 v108, 6, v0
    v_add_u32 v104, s84, v2
    v_readfirstlane_b32 s44, v108
    v_add_u32 v105, 4096, v104
    v_add_u32 v106, 8192, v104
    v_add_u32 v107, 12288, v104
    v_cmp_gt_u32 s[58:59], 53, v0
    v_lshlrev_b32 v3, 4, v0
    v_mov_b32 v5, 0
    v_mov_b32 v108, 4194303
    v_mov_b32 v109, 4194303
    v_mov_b32 v110, 4194303
    v_mov_b32 v111, 4194303
    s_waitcnt lgkmcnt(0)
    global_load_dword v125, v5, s[18:19]
    s_mov_b64 exec, s[58:59]
    s_cbranch_execz A_no3a
    global_load_dword v43, v107, s[8:9]
    global_load_dword v47, v107, s[6:7]
A_no3a:
    s_mov_b64 exec, -1
    global_load_dword v40, v104, s[8:9]
    global_load_dword v41, v105, s[8:9]
    global_load_dword v42, v106, s[8:9]
    global_load_dword v44, v104, s[6:7]
    global_load_dword v45, v105, s[6:7]
    global_load_dword v46, v106, s[6:7]
    v_add_u32 v104, 104448, v3
    ds_write_b128 v104, v[108:111]
    ds_write_b128 v104, v[108:111] offset:16384
    s_cmp_ge_u32 s44, 4
    s_cbranch_scc1 I_a
    ds_write_b128 v104, v[108:111] offset:32768
    ds_write_b32 v2, v5 offset:0
I_a:
    v_and_b32 v1, 63, v0
    v_mov_b32 v4, 4
    s_mov_b32 s20, s4
    s_mov_b32 s21, s5
    s_mov_b32 s22, 3200000
    s_mov_b32 s23, 0x00020000
    s_cmp_lt_u32 s44, 8
    s_cselect_b32 s32, s10, s12
    s_cselect_b32 s33, s11, s13
    v_lshrrev_b32 v104, 3, v1
    v_and_b32 v105, 7, v1
    v_xor_b32 v105, v105, v104
    v_lshlrev_b32 v105, 4, v105
    v_lshlrev_b32 v104, 19, v104
    s_lshl_b32 s84, s44, 15
    s_lshl_b32 s85, s2, 7
    s_add_u32 s84, s84, s85
    v_add3_u32 v6, v104, v105, s84
    s_lshl_b32 s84, s44, 10
    s_add_u32 m0, s84, 43008
    s_waitcnt lgkmcnt(0)
    s_barrier
    v_and_b32 v107, 0x1ff0, v3
    global_load_dwordx4 v[56:59], v107, s[32:33]
    s_mov_b32 s40, s18
    s_mov_b32 s41, s19
    s_mov_b32 s42, 8458240
    s_mov_b32 s43, 0x00020000
    v_add_u32 v104, 141312, v3
    ds_write_b128 v104, v[108:111]
    s_cmp_ge_u32 s44, 6
    s_cbranch_scc1 I_b
    ds_write_b128 v104, v[108:111] offset:16384
I_b:
    v_and_b32 v126, 15, v1
    v_mul_u32_u24 v126, 1408, v126
    v_add_u32 v126, 141312, v126
    v_and_b32 v124, 0x7c, v2
    s_cmp_lg_u32 s44, 12
    s_cbranch_scc1 I_done
    v_cmp_gt_u32 vcc, 16, v1
    s_mov_b32 exec_hi, 0
    s_nop 0
    v_cndmask_b32 v106, 0, v126, vcc
    ds_write_b32 v124, v106 offset:1024
    s_mov_b64 exec, 0xff
    v_cvt_f32_u32 v106, v1
    v_mul_f32 v107, v106, v106
    v_cvt_pk_bf16_f32 v106, v107, v106
    v_lshlrev_b32 v107, 4, v1
    ds_write_b32 v107, v106 offset:1152
    s_mov_b64 exec, -1
I_done:
    s_lshl_b32 s84, s2, 8
    s_add_u32 s84, s84, 4096
    s_add_u32 s85, s84, 4227072
    s_lshr_b32 s45, s2, 2
    s_mul_i32 s45, s45, 66048
    s_and_b32 s88, s2, 3
    s_lshl_b32 s88, s88, 6
    s_add_u32 s45, s45, s88
    s_add_u32 s45, s45, 4096
    v_lshrrev_b32 v104, 2, v0
    v_and_b32 v105, 3, v0
    v_mul_u32_u24 v68, 144, v104
    v_lshl_add_u32 v68, v105, 2, v68
    v_add_u32 v68, 104448, v68
    v_lshrrev_b32 v106, 4, v0
    v_mul_u32_u24 v69, 66048, v106
    v_and_b32 v106, 255, v3
    v_add_u32 v69, v69, v106
    v_lshlrev_b32 v105, 4, v105
    v_lshl_add_u32 v121, v104, 8, v105
    s_mov_b32 s54, 4194303
    s_mov_b32 s94, 104448
    s_mov_b32 s92, 0x88888888
    s_mov_b32 s93, 0x88888888
    v_bfe_u32 v104, v0, 3, 6
    v_and_b32 v105, 7, v0
    v_bfe_u32 v106, v104, 1, 1
    v_and_or_b32 v106, v104, 8, v106
    v_bfe_u32 v107, v104, 1, 2
    s_cmp_lt_u32 s44, 8
    s_cselect_b64 s[88:89], -1, 0
    s_mov_b32 s90, 2048
    s_cselect_b32 s90, 75776, s90
    s_bfe_u32 s91, s44, 0x20002
    s_cmp_eq_u32 s91, 1
    s_cselect_b32 s91, 4096, 0
    s_add_u32 s90, s90, s91
    v_cndmask_b32 v106, v107, v106, s[88:89]
    v_lshlrev_b32 v105, 1, v105
    v_xor_b32 v105, v105, v106
    v_lshlrev_b32 v105, 3, v105
    v_lshl_add_u32 v105, v104, 7, v105
    v_add_u32 v70, s90, v105
    v_xor_b32 v71, 8, v70
    v_bfrev_b32 v108, -2
    s_waitcnt vmcnt(4)
    v_lshlrev_b32_sdwa v48, 2, v40 dst_sel:DWORD dst_unused:UNUSED_PAD src0_sel:DWORD src1_sel:BYTE_0
    ds_add_rtn_u32 v52, v48, v4 offset:0
    v_lshlrev_b32_sdwa v49, 2, v41 dst_sel:DWORD dst_unused:UNUSED_PAD src0_sel:DWORD src1_sel:BYTE_0
    ds_add_rtn_u32 v53, v49, v4 offset:0
    v_lshlrev_b32_sdwa v50, 2, v42 dst_sel:DWORD dst_unused:UNUSED_PAD src0_sel:DWORD src1_sel:BYTE_0
    ds_add_rtn_u32 v54, v50, v4 offset:0
    s_waitcnt vmcnt(1)
    v_lshrrev_b32 v40, 8, v40
    v_lshl_or_b32 v44, v44, 7, v40
    v_mad_u32_u24 v48, v48, 36, s94
    v_lshrrev_b32 v41, 8, v41
    v_lshl_or_b32 v45, v45, 7, v41
    v_mad_u32_u24 v49, v49, 36, s94
    v_lshrrev_b32 v42, 8, v42
    v_lshl_or_b32 v46, v46, 7, v42
    v_mad_u32_u24 v50, v50, 36, s94
    s_waitcnt lgkmcnt(2)
    v_min_u32 v52, 140, v52
    v_add_u32 v52, v52, v48
    ds_write_b32 v52, v44
    s_waitcnt lgkmcnt(2)
    v_min_u32 v53, 140, v53
    v_add_u32 v53, v53, v49
    ds_write_b32 v53, v45
    s_waitcnt lgkmcnt(2)
    v_min_u32 v54, 140, v54
    v_add_u32 v54, v54, v50
    ds_write_b32 v54, v46
    s_mov_b64 exec, s[58:59]
    s_cbranch_execz A_no3b
    v_lshlrev_b32_sdwa v51, 2, v43 dst_sel:DWORD dst_unused:UNUSED_PAD src0_sel:DWORD src1_sel:BYTE_0
    ds_add_rtn_u32 v55, v51, v4 offset:0
    v_lshrrev_b32 v43, 8, v43
    v_lshl_or_b32 v47, v47, 7, v43
    v_mad_u32_u24 v51, v51, 36, s94
    s_waitcnt lgkmcnt(0)
    v_min_u32 v55, 140, v55
    v_add_u32 v55, v55, v51
    ds_write_b32 v55, v47
A_no3b:
    s_mov_b64 exec, -1
    s_waitcnt vmcnt(1)
    v_readfirstlane_b32 s34, v125
    s_add_u32 s34, s34, 1
    s_lshl_b32 s50, s34, 22
    s_lshl_b32 s51, s34, 12
    s_and_b32 s51, s51, 0xffc00000
    s_lshl_b32 s52, s34, 2
    s_and_b32 s52, s52, 0xffc00000
    s_add_u32 s51, s51, s50
    s_add_u32 s52, s52, s50
    s_xor_b32 s53, s50, 0xffc00000
    s_waitcnt lgkmcnt(0)
    s_barrier
    ds_read_b32 v48, v68 offset:128
    ds_read2_b32 v[40:41], v68 offset0:0 offset1:4
    ds_read2_b32 v[42:43], v68 offset0:8 offset1:12
    ds_read2_b32 v[44:45], v68 offset0:16 offset1:20
    ds_read2_b32 v[46:47], v68 offset0:24 offset1:28
    s_waitcnt lgkmcnt(4)
    v_cmp_ne_u32 vcc, s54, v48
    s_waitcnt lgkmcnt(2)
    s_cbranch_vccnz A_full
A_pub:
    v_cmp_ne_u32 vcc, s54, v43
    v_or_b32 v40, s50, v40
    v_or_b32 v41, s51, v41
    v_or_b32 v42, s52, v42
    v_or_b32 v43, s53, v43
    buffer_store_dwordx4 v[40:43], v69, s[40:43], s84 offen sc1
    s_and_b64 s[88:89], vcc, s[92:93]
    s_lshr_b64 s[90:91], s[88:89], 4
    s_or_b64 s[88:89], s[88:89], s[90:91]
    s_and_b32 s88, s88, 0x08080808
    s_and_b32 s89, s89, 0x08080808
    s_lshl_b64 s[90:91], s[88:89], 4
    s_or_b64 s[88:89], s[88:89], s[90:91]
    s_wqm_b64 vcc, s[88:89]
    s_waitcnt lgkmcnt(0)
    v_or_b32 v44, s50, v44
    v_or_b32 v45, s51, v45
    v_or_b32 v46, s52, v46
    v_or_b32 v47, s53, v47
    v_cndmask_b32 v69, v108, v69, vcc
    buffer_store_dwordx4 v[44:47], v69, s[40:43], s85 offen sc1
    s_waitcnt vmcnt(2)
    ds_write_b64 v70, v[56:57]
    ds_write_b64 v71, v[58:59]
    v_lshrrev_b32 v109, 4, v1
    v_bfe_u32 v105, v1, 2, 2
    v_lshl_add_u32 v106, v109, 3, v105
    v_bfe_u32 v107, v106, 1, 1
    v_and_or_b32 v107, v106, 8, v107
    v_and_b32 v108, 3, v1
    v_lshlrev_b32 v110, 1, v108
    v_xor_b32 v107, v107, v110
    v_lshlrev_b32 v107, 3, v107
    v_lshl_add_u32 v104, v106, 7, v107
    v_add_u32 v88, 75776, v104
    v_xor_b32 v89, 8, v88
    v_xor_b32 v90, 64, v88
    v_xor_b32 v91, 0x48, v88
    v_and_b32 v111, 7, v1
    v_xor_b32 v104, v109, v111
    v_lshlrev_b32 v104, 4, v104
    v_lshl_add_u32 v104, v111, 7, v104
    s_lshl_b32 s84, s44, 13
    s_add_u32 s84, s84, 17408
    v_add_u32 v92, s84, v104
    v_xor_b32 v93, 64, v92
    s_mov_b32 s36, s14
    s_mov_b32 s37, s15
    s_mov_b32 s38, 3200000
    s_mov_b32 s39, 0x00020000
    s_mov_b32 s24, s6
    s_mov_b32 s25, s7
    s_mov_b32 s26, 3200000
    s_mov_b32 s27, 0x00020000
    s_mov_b32 s28, s8
    s_mov_b32 s29, s9
    s_mov_b32 s30, 3200000
    s_mov_b32 s31, 0x00020000
    s_add_u32 s86, s45, 4227072
    s_mov_b32 s46, 0x003fff80
    s_lshl_b32 s47, s44, 13
    s_add_u32 s47, s47, 10240
    s_mov_b32 s55, 0
    s_mov_b32 s3, 0
    s_mov_b32 s56, 0x00ff00ff
    s_mov_b32 s57, 0x00ff00ff
    v_and_b32 v105, 15, v1
    v_lshrrev_b32 v104, 3, v1
    v_and_b32 v110, 6, v104
    v_xor_b32 v110, v110, v111
    v_lshlrev_b32 v102, 4, v110
    s_mul_i32 s84, s44, 1408
    s_add_u32 s84, s84, 141312
    v_lshl_add_u32 v103, v104, 4, s84
    v_bfe_u32 v110, v1, 3, 2
    v_lshl_add_u32 v110, v111, 2, v110
    v_lshl_add_u32 v120, v110, 2, s84
    v_and_b32 v110, 6, v105
    v_xor_b32 v110, v110, v109
    v_lshlrev_b32 v110, 4, v110
    v_lshl_add_u32 v110, v105, 7, v110
    v_add_u32 v94, s47, v110
    v_xor_b32 v95, 64, v94
    v_lshrrev_b32 v110, 2, v1
    v_and_b32 v105, 6, v110
    v_bfe_u32 v109, v1, 1, 1
    v_xor_b32 v105, v105, v109
    v_lshlrev_b32 v105, 4, v105
    v_lshl_add_u32 v105, v110, 7, v105
    v_and_b32 v109, 1, v1
    v_lshl_add_u32 v105, v109, 3, v105
    v_add_u32 v96, s47, v105
    v_xor_b32 v97, 32, v96
    v_xor_b32 v98, 64, v96
    v_xor_b32 v99, 0x60, v96
    v_bfe_u32 v109, v110, 1, 2
    v_lshl_or_b32 v109, v108, 2, v109
    v_lshlrev_b32 v109, 3, v109
    v_lshl_add_u32 v7, v110, 7, v109
    v_lshrrev_b32 v109, 3, v1
    v_and_b32 v109, 6, v109
    v_xor_b32 v109, v109, v111
    v_lshlrev_b32 v109, 4, v109
    v_lshl_add_u32 v109, v111, 7, v109
    v_add_u32 v125, s47, v109
    v_mov_b32 v81, 0x00003f80
    v_mov_b32 v82, 0
    v_mov_b32 v83, 0
    v_mov_b32 v84, 0
    v_mov_b32 v85, 0
    v_mov_b32 v86, 0
    v_mov_b32 v87, 0
    v_cvt_f32_u32 v109, v111
    v_mov_b32 v110, 0x71800000
    v_mul_f32 v111, v109, v110
    v_mul_f32 v109, v109, v111
    v_mul_f32 v111, -2.0, v111
    s_mov_b32 exec_lo, 0xff0000ff
    s_mov_b32 exec_hi, 0
    v_cvt_pk_bf16_f32 v84, v110, v111
    v_cvt_pk_bf16_f32 v85, v109, 0
    s_mov_b64 exec, -1
    v_mov_b32 v8, 0
    v_mov_b32 v9, 0
    v_mov_b32 v10, 0
    v_mov_b32 v11, 0
    v_mov_b32 v12, 0
    v_mov_b32 v13, 0
    v_mov_b32 v14, 0
    v_mov_b32 v15, 0
    v_mov_b32 v116, 4194303
    v_mov_b32 v117, 4194303
    v_mov_b32 v118, 4194303
    v_mov_b32 v119, 4194303
    s_mov_b32 s96, 0
    s_mov_b32 s94, 0x400000
    s_mov_b32 s87, 4194302
    s_mov_b64 s[88:89], -1
    s_mov_b64 s[90:91], 0
    s_waitcnt vmcnt(0) lgkmcnt(0)
    s_barrier
    buffer_load_dwordx4 v[112:115], v121, s[40:43], s45 offen sc1
    ds_read_b64_tr_b16 v[24:25], v88 offset:0
    ds_read_b64_tr_b16 v[26:27], v88 offset:512
    ds_read_b64_tr_b16 v[28:29], v88 offset:8192
    ds_read_b64_tr_b16 v[30:31], v88 offset:8704
    ds_read_b64_tr_b16 v[32:33], v89 offset:0
    ds_read_b64_tr_b16 v[34:35], v89 offset:512
    ds_read_b64_tr_b16 v[36:37], v89 offset:8192
    ds_read_b64_tr_b16 v[38:39], v89 offset:8704
    ds_read_b64_tr_b16 v[56:57], v90 offset:0
    ds_read_b64_tr_b16 v[58:59], v90 offset:512
    ds_read_b64_tr_b16 v[60:61], v90 offset:8192
    ds_read_b64_tr_b16 v[62:63], v90 offset:8704
    s_waitcnt lgkmcnt(8)
    ds_read_b64_tr_b16 v[64:65], v91 offset:0
    ds_read_b64_tr_b16 v[66:67], v91 offset:512
    ds_read_b64_tr_b16 v[68:69], v91 offset:8192
    ds_read_b64_tr_b16 v[70:71], v91 offset:8704
    s_mov_b32 s35, 0
    v_mov_b32 v100, v103
    v_mov_b32 v101, v120
    s_waitcnt vmcnt(0)
K_seen:
    s_setprio 3
    v_xor_b32 v112, s50, v112
    v_xor_b32 v113, s51, v113
    v_xor_b32 v114, s52, v114
    v_xor_b32 v115, s53, v115
    v_or3_b32 v104, v112, v113, v114
    v_or_b32 v104, v104, v115
    v_cmp_le_u32 vcc, s94, v104
    s_wqm_b64 vcc, vcc
    s_andn2_b64 s[60:61], s[88:89], vcc
    s_mov_b64 s[88:89], vcc
    s_mov_b64 exec, vcc
    s_cbranch_execz Z_nra
    s_add_u32 s96, s96, 1
    s_cmp_gt_u32 s96, 2000
    s_cbranch_scc1 Z_givea
    buffer_load_dwordx4 v[112:115], v121, s[40:43], s45 offen sc1
Z_nra:
    s_mov_b64 exec, s[60:61]
    s_cbranch_execz Z_donea
    v_cmp_ne_u32 s[62:63], s54, v115
    v_cmp_eq_u32 vcc, s87, v112
    s_and_b64 s[62:63], s[62:63], s[92:93]
    s_wqm_b64 exec, s[62:63]
    s_cbranch_execz Z_nha
    s_or_b64 s[90:91], s[90:91], exec
    buffer_load_dwordx4 v[116:119], v121, s[40:43], s86 offen sc1
Z_nha:
    s_cbranch_vccnz Z_fulla
Z_ranka:
    s_mov_b64 exec, s[60:61]
    v_min_u32 v104, v112, v113
    v_max_u32 v113, v112, v113
    v_min_u32 v105, v114, v115
    v_max_u32 v115, v114, v115
    v_min_u32 v112, v104, v105
    v_max_u32 v114, v104, v105
    v_cmp_ne_u32 s[68:69], s54, v112
    v_and_b32 v40, 15, v112
    v_lshlrev_b32 v40, 2, v40
    s_mov_b64 exec, s[68:69]
    ds_add_rtn_u32 v48, v40, v4 offset:1024
    s_mov_b64 exec, s[60:61]
    s_waitcnt lgkmcnt(0)
    s_mov_b64 exec, s[68:69]
    ds_write_b32 v48, v112
Z_donea:
    s_mov_b64 exec, -1
    s_add_u32 m0, s47, 7168
    s_nop 0
    buffer_load_dwordx4 v6, s[20:23], 0 offen lds
    s_mov_b32 s97, 2
    s_mov_b64 exec, -1
    s_waitcnt lgkmcnt(0)
    s_barrier
    s_cmp_lt_u32 s44, 4
    s_cbranch_scc1 G_more
    s_call_b64 s[10:11], L_s2
    s_cmp_lt_u32 s44, 8
    s_cbranch_scc1 G_more
    s_cmp_eq_u32 s97, 0
    s_cbranch_scc1 G_more
    s_waitcnt vmcnt(1)
    s_call_b64 s[10:11], L_late
G_more:
    ds_read_b32 v105, v5 offset:1128
    ds_read_b128 v[88:91], v103
    ds_read_b128 v[108:111], v103 offset:128
    s_cmp_eq_u32 s35, 1
    s_waitcnt lgkmcnt(0)
    s_cbranch_scc1 G_m1
    v_max3_u32 v104, v88, v89, v90
    v_max_u32 v104, v104, v91
    v_cmp_eq_u32 vcc, s54, v104
    s_cbranch_vccnz G_short
    s_mov_b32 m0, s47
    v_and_or_b32 v88, v88, s46, v102
    buffer_load_dwordx4 v88, s[20:23], 0 offen lds
    s_add_u32 m0, m0, 1024
    v_and_or_b32 v89, v89, s46, v102
    buffer_load_dwordx4 v89, s[20:23], 0 offen lds
    s_add_u32 m0, m0, 1024
    v_and_or_b32 v90, v90, s46, v102
    buffer_load_dwordx4 v90, s[20:23], 0 offen lds
    s_add_u32 m0, m0, 1024
    v_and_or_b32 v91, v91, s46, v102
    buffer_load_dwordx4 v91, s[20:23], 0 offen lds
    s_mov_b32 s35, 1
G_m1:
    v_max3_u32 v104, v108, v109, v110
    v_max_u32 v104, v104, v111
    v_cmp_eq_u32 vcc, s54, v104
    s_cbranch_vccnz G_short
    s_add_u32 m0, s47, 4096
    v_and_or_b32 v108, v108, s46, v102
    buffer_load_dwordx4 v108, s[20:23], 0 offen lds
    s_add_u32 m0, m0, 1024
    v_and_or_b32 v109, v109, s46, v102
    buffer_load_dwordx4 v109, s[20:23], 0 offen lds
    s_add_u32 m0, m0, 1024
    v_and_or_b32 v110, v110, s46, v102
    buffer_load_dwordx4 v110, s[20:23], 0 offen lds
    s_mov_b32 s35, 2
    s_cmp_lg_u32 s97, 2
    s_cbranch_scc1 G_q
    s_call_b64 s[10:11], L_s2
G_q:
    s_waitcnt vmcnt(7)
    s_mov_b64 exec, s[56:57]
    ds_read_b128 v[8:11], v92
    ds_read_b128 v[12:15], v93
    s_mov_b64 exec, -1
    s_waitcnt lgkmcnt(0)
    s_add_u32 m0, s47, 7168
    v_and_or_b32 v111, v111, s46, v102
    buffer_load_dwordx4 v111, s[20:23], 0 offen lds
    v_mfma_f32_16x16x32_bf16 v[16:19], v[24:27], v[8:11], 0
    v_mfma_f32_16x16x32_bf16 v[16:19], v[28:31], v[12:15], v[16:19]
    v_mfma_f32_16x16x32_bf16 v[20:23], v[32:35], v[8:11], 0
    v_mfma_f32_16x16x32_bf16 v[20:23], v[36:39], v[12:15], v[20:23]
    v_mfma_f32_16x16x32_bf16 v[72:75], v[56:59], v[8:11], 0
    v_mfma_f32_16x16x32_bf16 v[72:75], v[60:63], v[12:15], v[72:75]
    v_mfma_f32_16x16x32_bf16 v[76:79], v[64:67], v[8:11], 0
    v_mfma_f32_16x16x32_bf16 v[76:79], v[68:71], v[12:15], v[76:79]
    v_mov_b32 v24, 0
    v_mov_b32 v25, 0
    v_mov_b32 v26, 0
    v_mov_b32 v27, 0
    v_mov_b32 v28, 0
    v_mov_b32 v29, 0
    v_mov_b32 v30, 0
    v_mov_b32 v31, 0
    v_mov_b32 v32, 0
    v_mov_b32 v33, 0
    v_mov_b32 v34, 0
    v_mov_b32 v35, 0
    v_mov_b32 v36, 0
    v_mov_b32 v37, 0
    v_mov_b32 v38, 0
    v_mov_b32 v39, 0
G_go:
    s_setprio 2
    s_mov_b32 s84, 0xbe38aa3b
    s_mov_b32 s85, s84
    s_nop 1
    v_pk_mul_f32 v[16:17], v[16:17], s[84:85]
    v_pk_mul_f32 v[18:19], v[18:19], s[84:85]
    v_pk_mul_f32 v[20:21], v[20:21], s[84:85]
    v_pk_mul_f32 v[22:23], v[22:23], s[84:85]
    v_pk_mul_f32 v[72:73], v[72:73], s[84:85]
    v_pk_mul_f32 v[74:75], v[74:75], s[84:85]
    v_pk_mul_f32 v[76:77], v[76:77], s[84:85]
    v_pk_mul_f32 v[78:79], v[78:79], s[84:85]
    v_cvt_pk_bf16_f32 v8, v16, v17
    v_cvt_pk_bf16_f32 v9, v18, v19
    v_cvt_pk_bf16_f32 v10, v20, v21
    v_cvt_pk_bf16_f32 v11, v22, v23
    v_cvt_pk_bf16_f32 v12, v72, v73
    v_cvt_pk_bf16_f32 v13, v74, v75
    v_cvt_pk_bf16_f32 v14, v76, v77
    v_cvt_pk_bf16_f32 v15, v78, v79
    v_mov_b32_dpp v16, v8 row_ror:8 row_mask:0xf bank_mask:0xf
    v_mov_b32_dpp v17, v9 row_ror:8 row_mask:0xf bank_mask:0xf
    v_mov_b32_dpp v18, v10 row_ror:8 row_mask:0xf bank_mask:0xf
    v_mov_b32_dpp v19, v11 row_ror:8 row_mask:0xf bank_mask:0xf
    v_mov_b32_dpp v20, v12 row_ror:8 row_mask:0xf bank_mask:0xf
    v_mov_b32_dpp v21, v13 row_ror:8 row_mask:0xf bank_mask:0xf
    v_mov_b32_dpp v22, v14 row_ror:8 row_mask:0xf bank_mask:0xf
    v_mov_b32_dpp v23, v15 row_ror:8 row_mask:0xf bank_mask:0xf
    s_mov_b32 s48, 4
    s_mov_b32 s32, 0
B_go:
    ds_read_b32 v92, v101
    ds_read_b128 v[88:91], v100 offset:256
    s_mov_b32 s49, 1
    s_waitcnt lgkmcnt(1)
    v_and_b32 v92, 0x70, v92
B_loop:
    s_cmp_lt_u32 s49, 2
    s_cbranch_scc1 B_p0
    s_setprio 1
    s_cmp_lt_u32 s49, 4
    s_cbranch_scc1 B_p0
    s_sub_u32 s84, s48, s49
    s_cmp_ge_u32 s84, 2
    s_cbranch_scc1 B_p0
    s_setprio 0
B_p0:
    ds_read_b32 v80, v92 offset:1152
    ds_read_b32 v93, v101 offset:128
    s_cmp_lt_u32 s49, s48
    s_cbranch_scc1 B_w4_0
    s_waitcnt vmcnt(0)
B_w4_0:
    s_cmp_lg_u32 s97, 0
    s_waitcnt vmcnt(4)
    s_cbranch_scc0 B_rd_0
    s_call_b64 s[10:11], L_late
B_rd_0:
    ds_read_b128 v[40:43], v94 offset:0
    ds_read_b128 v[44:47], v95 offset:0
    ds_read_b128 v[48:51], v94 offset:2048
    ds_read_b128 v[52:55], v95 offset:2048
    ds_read_b64_tr_b16 v[56:57], v96 offset:0
    ds_read_b64_tr_b16 v[58:59], v96 offset:2048
    ds_read_b64_tr_b16 v[60:61], v97 offset:0
    ds_read_b64_tr_b16 v[62:63], v97 offset:2048
    ds_read_b64_tr_b16 v[64:65], v98 offset:0
    ds_read_b64_tr_b16 v[66:67], v98 offset:2048
    ds_read_b64_tr_b16 v[68:69], v99 offset:0
    ds_read_b64_tr_b16 v[70:71], v99 offset:2048
    s_add_u32 s49, s49, 1
    s_waitcnt lgkmcnt(12)
    v_mfma_f32_16x16x32_bf16 v[72:75], v[80:83], v[84:87], 0
    v_and_b32 v93, 0x70, v93
    s_waitcnt lgkmcnt(11)
    v_mfma_f32_16x16x32_bf16 v[72:75], v[40:43], v[8:11], v[72:75]
    s_waitcnt lgkmcnt(10)
    v_mfma_f32_16x16x32_bf16 v[72:75], v[44:47], v[12:15], v[72:75]
    s_waitcnt lgkmcnt(9)
    v_mfma_f32_16x16x32_bf16 v[72:75], v[48:51], v[16:19], v[72:75]
    s_waitcnt lgkmcnt(8)
    v_mfma_f32_16x16x32_bf16 v[72:75], v[52:55], v[20:23], v[72:75]
    s_waitcnt lgkmcnt(0)
    s_cmp_lt_u32 s49, s32
    s_cbranch_scc0 B_skip_0
B_dma_0:
    s_mov_b32 m0, s47
    v_and_or_b32 v88, v88, s46, v102
    buffer_load_dwordx4 v88, s[20:23], 0 offen lds
    s_add_u32 m0, m0, 1024
    v_and_or_b32 v89, v89, s46, v102
    buffer_load_dwordx4 v89, s[20:23], 0 offen lds
    s_add_u32 m0, m0, 1024
    v_and_or_b32 v90, v90, s46, v102
    buffer_load_dwordx4 v90, s[20:23], 0 offen lds
    s_add_u32 m0, m0, 1024
    v_and_or_b32 v91, v91, s46, v102
    buffer_load_dwordx4 v91, s[20:23], 0 offen lds
    ds_read_b128 v[88:91], v100 offset:384
B_cont_0:
    v_exp_f32 v72, v72
    v_exp_f32 v73, v73
    v_exp_f32 v74, v74
    v_exp_f32 v75, v75
    v_add_f32 v72, 1.0, v72
    v_add_f32 v73, 1.0, v73
    v_add_f32 v74, 1.0, v74
    v_add_f32 v75, 1.0, v75
    v_rcp_f32 v72, v72
    v_rcp_f32 v73, v73
    v_rcp_f32 v74, v74
    v_rcp_f32 v75, v75
    v_cvt_pk_bf16_f32 v76, v72, v73
    s_cmp_gt_u32 s49, s48
    v_cvt_pk_bf16_f32 v77, v74, v75
    s_nop 0
    v_mov_b32_dpp v78, v76 row_ror:8 row_mask:0xf bank_mask:0xf
    v_mov_b32_dpp v79, v77 row_ror:8 row_mask:0xf bank_mask:0xf
    s_nop 1
    v_mfma_f32_16x16x32_bf16 v[24:27], v[56:59], v[76:79], v[24:27]
    v_mfma_f32_16x16x32_bf16 v[28:31], v[60:63], v[76:79], v[28:31]
    v_mfma_f32_16x16x32_bf16 v[32:35], v[64:67], v[76:79], v[32:35]
    v_mfma_f32_16x16x32_bf16 v[36:39], v[68:71], v[76:79], v[36:39]
    s_cbranch_scc1 B_loopdone
    ds_read_b32 v80, v93 offset:1152
    ds_read_b32 v92, v101 offset:256
    s_cmp_lt_u32 s49, s48
    s_cbranch_scc1 B_w4_1
    s_waitcnt vmcnt(0)
B_w4_1:
    s_cmp_lg_u32 s97, 0
    s_waitcnt vmcnt(4)
    s_cbranch_scc0 B_rd_1
    s_call_b64 s[10:11], L_late
B_rd_1:
    ds_read_b128 v[40:43], v94 offset:4096
    ds_read_b128 v[44:47], v95 offset:4096
    ds_read_b128 v[48:51], v94 offset:6144
    ds_read_b128 v[52:55], v95 offset:6144
    ds_read_b64_tr_b16 v[56:57], v96 offset:4096
    ds_read_b64_tr_b16 v[58:59], v96 offset:6144
    ds_read_b64_tr_b16 v[60:61], v97 offset:4096
    ds_read_b64_tr_b16 v[62:63], v97 offset:6144
    ds_read_b64_tr_b16 v[64:65], v98 offset:4096
    ds_read_b64_tr_b16 v[66:67], v98 offset:6144
    ds_read_b64_tr_b16 v[68:69], v99 offset:4096
    ds_read_b64_tr_b16 v[70:71], v99 offset:6144
    s_add_u32 s49, s49, 1
    s_waitcnt lgkmcnt(12)
    v_mfma_f32_16x16x32_bf16 v[72:75], v[80:83], v[84:87], 0
    v_and_b32 v92, 0x70, v92
    s_waitcnt lgkmcnt(11)
    v_mfma_f32_16x16x32_bf16 v[72:75], v[40:43], v[8:11], v[72:75]
    s_waitcnt lgkmcnt(10)
    v_mfma_f32_16x16x32_bf16 v[72:75], v[44:47], v[12:15], v[72:75]
    s_waitcnt lgkmcnt(9)
    v_mfma_f32_16x16x32_bf16 v[72:75], v[48:51], v[16:19], v[72:75]
    s_waitcnt lgkmcnt(8)
    v_mfma_f32_16x16x32_bf16 v[72:75], v[52:55], v[20:23], v[72:75]
    s_waitcnt lgkmcnt(0)
    s_cmp_lt_u32 s49, s32
    s_cbranch_scc0 B_skip_1
B_dma_1:
    s_add_u32 m0, s47, 4096
    v_and_or_b32 v88, v88, s46, v102
    buffer_load_dwordx4 v88, s[20:23], 0 offen lds
    s_add_u32 m0, m0, 1024
    v_and_or_b32 v89, v89, s46, v102
    buffer_load_dwordx4 v89, s[20:23], 0 offen lds
    s_add_u32 m0, m0, 1024
    v_and_or_b32 v90, v90, s46, v102
    buffer_load_dwordx4 v90, s[20:23], 0 offen lds
    s_add_u32 m0, m0, 1024
    v_and_or_b32 v91, v91, s46, v102
    buffer_load_dwordx4 v91, s[20:23], 0 offen lds
    ds_read_b128 v[88:91], v100 offset:512
B_cont_1:
    v_exp_f32 v72, v72
    v_exp_f32 v73, v73
    v_exp_f32 v74, v74
    v_exp_f32 v75, v75
    v_add_u32 v100, 256, v100
    v_add_u32 v101, 256, v101
    v_add_f32 v72, 1.0, v72
    v_add_f32 v73, 1.0, v73
    v_add_f32 v74, 1.0, v74
    v_add_f32 v75, 1.0, v75
    v_rcp_f32 v72, v72
    v_rcp_f32 v73, v73
    v_rcp_f32 v74, v74
    v_rcp_f32 v75, v75
    v_cvt_pk_bf16_f32 v76, v72, v73
    s_cmp_gt_u32 s49, s48
    v_cvt_pk_bf16_f32 v77, v74, v75
    s_nop 0
    v_mov_b32_dpp v78, v76 row_ror:8 row_mask:0xf bank_mask:0xf
    v_mov_b32_dpp v79, v77 row_ror:8 row_mask:0xf bank_mask:0xf
    s_nop 1
    v_mfma_f32_16x16x32_bf16 v[24:27], v[56:59], v[76:79], v[24:27]
    v_mfma_f32_16x16x32_bf16 v[28:31], v[60:63], v[76:79], v[28:31]
    v_mfma_f32_16x16x32_bf16 v[32:35], v[64:67], v[76:79], v[32:35]
    v_mfma_f32_16x16x32_bf16 v[36:39], v[68:71], v[76:79], v[36:39]
    s_cbranch_scc0 B_loop
B_loopdone:
    s_cmp_lg_u32 s55, 0
    s_cbranch_scc1 C_next
B_epi:
    s_cmp_lg_u32 s35, 3
    s_cbranch_scc0 E_have
    v_xor_b32 v105, 8, v7
    v_xor_b32 v106, 16, v7
    v_xor_b32 v107, 24, v7
    ds_read_b64_tr_b16 v[40:41], v7 offset:2048
    ds_read_b64_tr_b16 v[42:43], v7 offset:4096
    ds_read_b64_tr_b16 v[44:45], v7 offset:6144
    ds_read_b64_tr_b16 v[46:47], v7 offset:8192
    ds_read_b64_tr_b16 v[48:49], v105 offset:2048
    ds_read_b64_tr_b16 v[50:51], v105 offset:4096
    ds_read_b64_tr_b16 v[52:53], v105 offset:6144
    ds_read_b64_tr_b16 v[54:55], v105 offset:8192
    ds_read_b64_tr_b16 v[8:9], v106 offset:2048
    ds_read_b64_tr_b16 v[10:11], v106 offset:4096
    ds_read_b64_tr_b16 v[12:13], v106 offset:6144
    ds_read_b64_tr_b16 v[14:15], v106 offset:8192
E_have:
    s_waitcnt lgkmcnt(8)
    ds_read_b64_tr_b16 v[16:17], v107 offset:2048
    ds_read_b64_tr_b16 v[18:19], v107 offset:4096
    ds_read_b64_tr_b16 v[20:21], v107 offset:6144
    ds_read_b64_tr_b16 v[22:23], v107 offset:8192
    v_xor_b32 v110, 16, v125
    v_lshl_add_u32 v109, v1, 4, s47
    v_cvt_pk_bf16_f32 v72, v24, v25
    v_cvt_pk_bf16_f32 v73, v26, v27
    v_cvt_pk_bf16_f32 v74, v28, v29
    v_cvt_pk_bf16_f32 v75, v30, v31
    v_cvt_pk_bf16_f32 v76, v32, v33
    v_cvt_pk_bf16_f32 v77, v34, v35
    v_cvt_pk_bf16_f32 v78, v36, v37
    v_cvt_pk_bf16_f32 v79, v38, v39
    s_nop 0
    s_waitcnt lgkmcnt(8)
    v_mfma_f32_16x16x32_bf16 v[56:59], v[40:43], v[72:75], 0
    v_mfma_f32_16x16x32_bf16 v[56:59], v[44:47], v[76:79], v[56:59]
    s_waitcnt lgkmcnt(8)
    v_mfma_f32_16x16x32_bf16 v[60:63], v[48:51], v[72:75], 0
    v_mfma_f32_16x16x32_bf16 v[60:63], v[52:55], v[76:79], v[60:63]
    s_waitcnt lgkmcnt(4)
    v_mfma_f32_16x16x32_bf16 v[64:67], v[8:11], v[72:75], 0
    v_mfma_f32_16x16x32_bf16 v[64:67], v[12:15], v[76:79], v[64:67]
    s_waitcnt lgkmcnt(0)
    v_mfma_f32_16x16x32_bf16 v[68:71], v[16:19], v[72:75], 0
    v_mfma_f32_16x16x32_bf16 v[68:71], v[20:23], v[76:79], v[68:71]
    s_cmp_lg_u32 s44, 15
    s_cbranch_scc1 K_no2
    s_mov_b64 exec, 1
    s_cmp_lg_u32 s3, 0
    s_cbranch_scc1 K_ticket
K_adv:
    v_mov_b32 v104, s34
    global_store_dword v5, v104, s[18:19]
K_skip:
    s_mov_b64 exec, -1
K_no2:
    s_nop 2
    v_cvt_pk_bf16_f32 v40, v56, v57
    v_cvt_pk_bf16_f32 v41, v58, v59
    v_cvt_pk_bf16_f32 v42, v60, v61
    v_cvt_pk_bf16_f32 v43, v62, v63
    s_mov_b64 exec, s[56:57]
    ds_write_b128 v125, v[40:43]
    v_cvt_pk_bf16_f32 v44, v64, v65
    v_cvt_pk_bf16_f32 v45, v66, v67
    v_cvt_pk_bf16_f32 v46, v68, v69
    v_cvt_pk_bf16_f32 v47, v70, v71
    ds_write_b128 v110, v[44:47]
    s_mov_b64 exec, -1
    ds_read_b128 v[48:51], v109
    s_waitcnt lgkmcnt(0)
    buffer_store_dwordx4 v[48:51], v6, s[36:39], 0 offen sc1
L_end:
    s_endpgm
B_skip_0:
    s_cmp_lg_u32 s32, 0
    s_cbranch_scc1 B_idle_0
    s_mov_b32 s33, 0
    s_cmp_ge_u32 s49, 4
    s_cbranch_scc1 F_final
    v_max3_u32 v104, v88, v89, v90
    v_max_u32 v104, v104, v91
    v_cmp_eq_u32 vcc, s54, v104
    s_cbranch_vccnz B_again_0
    s_branch B_dma_0
B_again_0:
    ds_read_b128 v[88:91], v100 offset:256
    s_waitcnt lgkmcnt(0)
    v_max3_u32 v104, v88, v89, v90
    v_max_u32 v104, v104, v91
    v_cmp_eq_u32 vcc, s54, v104
    s_cbranch_vccnz F_final
    s_branch B_dma_0
F_ret_0:
    ds_read_b128 v[88:91], v100 offset:256
    s_waitcnt lgkmcnt(0)
    s_cmp_lt_u32 s49, s48
    s_cbranch_scc1 B_dma_0
B_idle_0:
    s_cmp_le_u32 s49, s48
    s_cbranch_scc1 B_id2_0
    s_cmp_lg_u32 s55, 0
    s_cbranch_scc1 B_id2_0
    s_mov_b32 s35, 3
    v_xor_b32 v105, 8, v7
    v_xor_b32 v106, 16, v7
    v_xor_b32 v107, 24, v7
    ds_read_b64_tr_b16 v[40:41], v7 offset:2048
    ds_read_b64_tr_b16 v[42:43], v7 offset:4096
    ds_read_b64_tr_b16 v[44:45], v7 offset:6144
    ds_read_b64_tr_b16 v[46:47], v7 offset:8192
    ds_read_b64_tr_b16 v[48:49], v105 offset:2048
    ds_read_b64_tr_b16 v[50:51], v105 offset:4096
    ds_read_b64_tr_b16 v[52:53], v105 offset:6144
    ds_read_b64_tr_b16 v[54:55], v105 offset:8192
    ds_read_b64_tr_b16 v[8:9], v106 offset:2048
    ds_read_b64_tr_b16 v[10:11], v106 offset:4096
    ds_read_b64_tr_b16 v[12:13], v106 offset:6144
    ds_read_b64_tr_b16 v[14:15], v106 offset:8192
    s_branch B_cont_0
B_id2_0:
    s_nop 7
    s_branch B_cont_0
B_skip_1:
    s_cmp_lg_u32 s32, 0
    s_cbranch_scc1 B_idle_1
    s_mov_b32 s33, 1
    s_cmp_ge_u32 s49, 4
    s_cbranch_scc1 F_final
    v_max3_u32 v104, v88, v89, v90
    v_max_u32 v104, v104, v91
    v_cmp_eq_u32 vcc, s54, v104
    s_cbranch_vccnz B_again_1
    s_branch B_dma_1
B_again_1:
    ds_read_b128 v[88:91], v100 offset:384
    s_waitcnt lgkmcnt(0)
    v_max3_u32 v104, v88, v89, v90
    v_max_u32 v104, v104, v91
    v_cmp_eq_u32 vcc, s54, v104
    s_cbranch_vccnz F_final
    s_branch B_dma_1
F_ret_1:
    ds_read_b128 v[88:91], v100 offset:384
    s_waitcnt lgkmcnt(0)
    s_cmp_lt_u32 s49, s48
    s_cbranch_scc1 B_dma_1
B_idle_1:
    s_cmp_le_u32 s49, s48
    s_cbranch_scc1 B_id2_1
    s_cmp_lg_u32 s55, 0
    s_cbranch_scc1 B_id2_1
    s_mov_b32 s35, 3
    v_xor_b32 v105, 8, v7
    v_xor_b32 v106, 16, v7
    v_xor_b32 v107, 24, v7
    ds_read_b64_tr_b16 v[40:41], v7 offset:2048
    ds_read_b64_tr_b16 v[42:43], v7 offset:4096
    ds_read_b64_tr_b16 v[44:45], v7 offset:6144
    ds_read_b64_tr_b16 v[46:47], v7 offset:8192
    ds_read_b64_tr_b16 v[48:49], v105 offset:2048
    ds_read_b64_tr_b16 v[50:51], v105 offset:4096
    ds_read_b64_tr_b16 v[52:53], v105 offset:6144
    ds_read_b64_tr_b16 v[54:55], v105 offset:8192
    ds_read_b64_tr_b16 v[8:9], v106 offset:2048
    ds_read_b64_tr_b16 v[10:11], v106 offset:4096
    ds_read_b64_tr_b16 v[12:13], v106 offset:6144
    ds_read_b64_tr_b16 v[14:15], v106 offset:8192
    s_branch B_cont_1
B_id2_1:
    s_nop 7
    s_branch B_cont_1
L_late:
    s_mov_b64 exec, s[90:91]
    s_cbranch_execz Y_done
    v_xor_b32 v116, s50, v116
    v_xor_b32 v117, s51, v117
    v_xor_b32 v118, s52, v118
    v_xor_b32 v119, s53, v119
    v_or3_b32 v104, v116, v117, v118
    v_or_b32 v104, v104, v119
    v_cmp_le_u32 vcc, s94, v104
    s_andn2_b64 s[60:61], s[90:91], vcc
    s_mov_b64 s[90:91], vcc
    s_mov_b64 exec, vcc
    s_cbranch_execz Y_nr
    s_add_u32 s96, s96, 1
    s_cmp_gt_u32 s96, 2000
    s_cbranch_scc1 Y_lost
    buffer_load_dwordx4 v[116:119], v121, s[40:43], s86 offen sc1
Y_nr:
    s_mov_b64 exec, s[60:61]
    v_cmp_ne_u32 s[76:77], s54, v116
    v_and_b32 v44, 15, v116
    v_lshlrev_b32 v44, 2, v44
    s_mov_b64 exec, s[76:77]
    s_cbranch_execz Y_done
    ds_add_rtn_u32 v52, v44, v4 offset:1024
    s_mov_b64 exec, s[60:61]
    s_waitcnt lgkmcnt(0)
    s_mov_b64 exec, s[76:77]
    ds_write_b32 v52, v116
    s_mov_b64 exec, s[60:61]
    v_cmp_ne_u32 s[78:79], s54, v117
    v_and_b32 v45, 15, v117
    v_lshlrev_b32 v45, 2, v45
    s_mov_b64 exec, s[78:79]
    s_cbranch_execz Y_done
    ds_add_rtn_u32 v53, v45, v4 offset:1024
    s_mov_b64 exec, s[60:61]
    s_waitcnt lgkmcnt(0)
    s_mov_b64 exec, s[78:79]
    ds_write_b32 v53, v117
    s_mov_b64 exec, s[60:61]
    v_cmp_ne_u32 s[80:81], s54, v118
    v_and_b32 v46, 15, v118
    v_lshlrev_b32 v46, 2, v46
    s_mov_b64 exec, s[80:81]
    s_cbranch_execz Y_done
    ds_add_rtn_u32 v54, v46, v4 offset:1024
    s_mov_b64 exec, s[60:61]
    s_waitcnt lgkmcnt(0)
    s_mov_b64 exec, s[80:81]
    ds_write_b32 v54, v118
    s_mov_b64 exec, s[60:61]
    v_cmp_ne_u32 s[82:83], s54, v119
    v_and_b32 v47, 15, v119
    v_lshlrev_b32 v47, 2, v47
    s_mov_b64 exec, s[82:83]
    s_cbranch_execz Y_done
    ds_add_rtn_u32 v55, v47, v4 offset:1024
    s_mov_b64 exec, s[60:61]
    s_waitcnt lgkmcnt(0)
    s_mov_b64 exec, s[82:83]
    ds_write_b32 v55, v119
    s_mov_b64 exec, s[60:61]
Y_done:
    s_mov_b64 exec, s[88:89]
    s_cbranch_execz Z_doneb
    v_xor_b32 v112, s50, v112
    v_xor_b32 v113, s51, v113
    v_xor_b32 v114, s52, v114
    v_xor_b32 v115, s53, v115
    v_or3_b32 v104, v112, v113, v114
    v_or_b32 v104, v104, v115
    v_cmp_le_u32 vcc, s94, v104
    s_wqm_b64 vcc, vcc
    s_andn2_b64 s[60:61], s[88:89], vcc
    s_mov_b64 s[88:89], vcc
    s_mov_b64 exec, vcc
    s_cbranch_execz Z_nrb
    s_add_u32 s96, s96, 1
    s_cmp_gt_u32 s96, 2000
    s_cbranch_scc1 Z_giveb
    buffer_load_dwordx4 v[112:115], v121, s[40:43], s45 offen sc1
Z_nrb:
    s_mov_b64 exec, s[60:61]
    s_cbranch_execz Z_doneb
    v_cmp_ne_u32 s[62:63], s54, v115
    v_cmp_eq_u32 vcc, s87, v112
    s_and_b64 s[62:63], s[62:63], s[92:93]
    s_wqm_b64 exec, s[62:63]
    s_cbranch_execz Z_nhb
    s_or_b64 s[90:91], s[90:91], exec
    buffer_load_dwordx4 v[116:119], v121, s[40:43], s86 offen sc1
Z_nhb:
    s_cbranch_vccnz Z_fullb
Z_rankb:
    s_mov_b64 exec, s[60:61]
    v_cmp_ne_u32 s[68:69], s54, v112
    v_and_b32 v40, 15, v112
    v_lshlrev_b32 v40, 2, v40
    s_mov_b64 exec, s[68:69]
    ds_add_rtn_u32 v48, v40, v4 offset:1024
    s_mov_b64 exec, s[60:61]
    v_cmp_ne_u32 s[70:71], s54, v113
    v_and_b32 v41, 15, v113
    v_lshlrev_b32 v41, 2, v41
    s_mov_b64 exec, s[70:71]
    ds_add_rtn_u32 v49, v41, v4 offset:1024
    s_mov_b64 exec, s[60:61]
    v_cmp_ne_u32 s[72:73], s54, v114
    v_and_b32 v42, 15, v114
    v_lshlrev_b32 v42, 2, v42
    s_mov_b64 exec, s[72:73]
    ds_add_rtn_u32 v50, v42, v4 offset:1024
    s_mov_b64 exec, s[60:61]
    v_cmp_ne_u32 s[74:75], s54, v115
    v_and_b32 v43, 15, v115
    v_lshlrev_b32 v43, 2, v43
    s_mov_b64 exec, s[74:75]
    ds_add_rtn_u32 v51, v43, v4 offset:1024
    s_mov_b64 exec, s[60:61]
    s_waitcnt lgkmcnt(3)
    s_mov_b64 exec, s[68:69]
    ds_write_b32 v48, v112
    s_waitcnt lgkmcnt(3)
    s_mov_b64 exec, s[70:71]
    ds_write_b32 v49, v113
    s_waitcnt lgkmcnt(3)
    s_mov_b64 exec, s[72:73]
    ds_write_b32 v50, v114
    s_waitcnt lgkmcnt(3)
    s_mov_b64 exec, s[74:75]
    ds_write_b32 v51, v115
Z_doneb:
    s_or_b64 exec, s[88:89], s[90:91]
    s_cbranch_execnz L_ret
    s_mov_b32 s97, 0
    s_mov_b64 exec, 1
    ds_add_u32 v5, v4 offset:1128
L_ret:
    s_mov_b64 exec, -1
    s_waitcnt lgkmcnt(0)
    s_setpc_b64 s[10:11]
G_short:
    v_readfirstlane_b32 s84, v105
    s_cmp_eq_u32 s97, 0
    s_cbranch_scc1 G_s2
    s_cmp_lg_u32 s97, 2
    s_cbranch_scc1 G_s1
    s_call_b64 s[10:11], L_s2
    s_branch G_more
L_s2:
    s_mov_b64 exec, s[60:61]
    v_cmp_ne_u32 s[70:71], s54, v113
    v_and_b32 v41, 15, v113
    v_lshlrev_b32 v41, 2, v41
    s_mov_b64 exec, s[70:71]
    ds_add_rtn_u32 v49, v41, v4 offset:1024
    s_mov_b64 exec, s[60:61]
    v_cmp_ne_u32 s[72:73], s54, v114
    v_and_b32 v42, 15, v114
    v_lshlrev_b32 v42, 2, v42
    s_mov_b64 exec, s[72:73]
    ds_add_rtn_u32 v50, v42, v4 offset:1024
    s_mov_b64 exec, s[60:61]
    v_cmp_ne_u32 s[74:75], s54, v115
    v_and_b32 v43, 15, v115
    v_lshlrev_b32 v43, 2, v43
    s_mov_b64 exec, s[74:75]
    ds_add_rtn_u32 v51, v43, v4 offset:1024
    s_mov_b64 exec, s[60:61]
    s_waitcnt lgkmcnt(2)
    s_mov_b64 exec, s[70:71]
    ds_write_b32 v49, v113
    s_waitcnt lgkmcnt(2)
    s_mov_b64 exec, s[72:73]
    ds_write_b32 v50, v114
    s_waitcnt lgkmcnt(2)
    s_mov_b64 exec, s[74:75]
    ds_write_b32 v51, v115
    s_or_b64 exec, s[88:89], s[90:91]
    s_cselect_b32 s97, 1, 0
    s_cbranch_execnz G_pend
    s_mov_b64 exec, 1
    ds_add_u32 v5, v4 offset:1128
G_pend:
    s_mov_b64 exec, -1
    s_waitcnt lgkmcnt(0)
    s_setpc_b64 s[10:11]
G_s1:
    s_waitcnt vmcnt(0)
    s_call_b64 s[10:11], L_late
    s_branch G_more
G_s2:
    s_setprio 0
    s_cmp_lt_u32 s84, 64
    s_cbranch_scc1 G_more
    s_waitcnt vmcnt(0)
    s_mov_b64 exec, s[56:57]
    ds_read_b128 v[8:11], v92
    ds_read_b128 v[12:15], v93
    s_mov_b64 exec, -1
    s_waitcnt lgkmcnt(0)
    v_mfma_f32_16x16x32_bf16 v[16:19], v[24:27], v[8:11], 0
    v_mfma_f32_16x16x32_bf16 v[16:19], v[28:31], v[12:15], v[16:19]
    v_mfma_f32_16x16x32_bf16 v[20:23], v[32:35], v[8:11], 0
    v_mfma_f32_16x16x32_bf16 v[20:23], v[36:39], v[12:15], v[20:23]
    v_mfma_f32_16x16x32_bf16 v[72:75], v[56:59], v[8:11], 0
    v_mfma_f32_16x16x32_bf16 v[72:75], v[60:63], v[12:15], v[72:75]
    v_mfma_f32_16x16x32_bf16 v[76:79], v[64:67], v[8:11], 0
    v_mfma_f32_16x16x32_bf16 v[76:79], v[68:71], v[12:15], v[76:79]
    v_mov_b32 v24, 0
    v_mov_b32 v25, 0
    v_mov_b32 v26, 0
    v_mov_b32 v27, 0
    v_mov_b32 v28, 0
    v_mov_b32 v29, 0
    v_mov_b32 v30, 0
    v_mov_b32 v31, 0
    v_mov_b32 v32, 0
    v_mov_b32 v33, 0
    v_mov_b32 v34, 0
    v_mov_b32 v35, 0
    v_mov_b32 v36, 0
    v_mov_b32 v37, 0
    v_mov_b32 v38, 0
    v_mov_b32 v39, 0
    s_mov_b32 s84, 0xbe38aa3b
    s_mov_b32 s85, s84
    s_nop 1
    v_pk_mul_f32 v[16:17], v[16:17], s[84:85]
    v_pk_mul_f32 v[18:19], v[18:19], s[84:85]
    v_pk_mul_f32 v[20:21], v[20:21], s[84:85]
    v_pk_mul_f32 v[22:23], v[22:23], s[84:85]
    v_pk_mul_f32 v[72:73], v[72:73], s[84:85]
    v_pk_mul_f32 v[74:75], v[74:75], s[84:85]
    v_pk_mul_f32 v[76:77], v[76:77], s[84:85]
    v_pk_mul_f32 v[78:79], v[78:79], s[84:85]
    v_cvt_pk_bf16_f32 v8, v16, v17
    v_cvt_pk_bf16_f32 v9, v18, v19
    v_cvt_pk_bf16_f32 v10, v20, v21
    v_cvt_pk_bf16_f32 v11, v22, v23
    v_cvt_pk_bf16_f32 v12, v72, v73
    v_cvt_pk_bf16_f32 v13, v74, v75
    v_cvt_pk_bf16_f32 v14, v76, v77
    v_cvt_pk_bf16_f32 v15, v78, v79
    v_mov_b32_dpp v16, v8 row_ror:8 row_mask:0xf bank_mask:0xf
    v_mov_b32_dpp v17, v9 row_ror:8 row_mask:0xf bank_mask:0xf
    v_mov_b32_dpp v18, v10 row_ror:8 row_mask:0xf bank_mask:0xf
    v_mov_b32_dpp v19, v11 row_ror:8 row_mask:0xf bank_mask:0xf
    v_mov_b32_dpp v20, v12 row_ror:8 row_mask:0xf bank_mask:0xf
    v_mov_b32_dpp v21, v13 row_ror:8 row_mask:0xf bank_mask:0xf
    v_mov_b32_dpp v22, v14 row_ror:8 row_mask:0xf bank_mask:0xf
    v_mov_b32_dpp v23, v15 row_ror:8 row_mask:0xf bank_mask:0xf
B_counts:
    s_mov_b32 s33, 2
F_final:
    s_cmp_eq_u32 s97, 0
    s_cbranch_scc1 F_spin
    s_waitcnt vmcnt(0)
    s_call_b64 s[10:11], L_late
    s_branch F_final
F_spin:
    ds_read_b32 v105, v124 offset:1024
    s_waitcnt lgkmcnt(0)
    v_readlane_b32 s84, v105, 26
    v_sub_u32 v107, v105, v126
    s_cmp_lt_u32 s84, 64
    s_cbranch_scc1 F_spin
    v_cmp_ne_u32 s[84:85], 0, v105
    v_cmp_lt_u32 vcc, 1408, v107
    v_readlane_b32 s48, v107, s44
    s_and_b32 s84, s84, 0x9ff0000
    s_and_b32 s85, vcc_lo, 0xffff
    s_or_b32 s32, s85, s84
    s_or_b32 s32, s32, s55
    s_cbranch_scc1 C_slowcnt
B_cntok:
    s_add_u32 s48, s48, 127
    s_lshr_b32 s48, s48, 7
    s_mov_b32 s32, s48
    s_cbranch_scc0 B_loopdone
    s_cmp_eq_u32 s33, 0
    s_cbranch_scc1 F_ret_0
    s_cmp_eq_u32 s33, 1
    s_cbranch_scc1 F_ret_1
    s_branch B_first
K_ticket:
    v_mov_b32 v105, 1
    global_atomic_add v122, v5, v105, s[16:17] sc0 sc1
    s_waitcnt vmcnt(0)
    v_readfirstlane_b32 s84, v122
    s_cmp_eq_u32 s84, 255
    s_cbranch_scc1 K_adv
    s_branch K_skip
B_first:
    ds_read_b128 v[40:43], v100
    ds_read_b128 v[44:47], v100 offset:128
    s_waitcnt lgkmcnt(0)
    s_cmp_eq_u32 s35, 1
    s_cbranch_scc1 B_f1
    s_mov_b32 m0, s47
    v_and_or_b32 v40, v40, s46, v102
    buffer_load_dwordx4 v40, s[20:23], 0 offen lds
    s_add_u32 m0, m0, 1024
    v_and_or_b32 v41, v41, s46, v102
    buffer_load_dwordx4 v41, s[20:23], 0 offen lds
    s_add_u32 m0, m0, 1024
    v_and_or_b32 v42, v42, s46, v102
    buffer_load_dwordx4 v42, s[20:23], 0 offen lds
    s_add_u32 m0, m0, 1024
    v_and_or_b32 v43, v43, s46, v102
    buffer_load_dwordx4 v43, s[20:23], 0 offen lds
B_f1:
    s_cmp_lt_u32 s48, 2
    s_cbranch_scc1 B_go
    s_add_u32 m0, s47, 4096
    v_and_or_b32 v44, v44, s46, v102
    buffer_load_dwordx4 v44, s[20:23], 0 offen lds
    s_add_u32 m0, m0, 1024
    v_and_or_b32 v45, v45, s46, v102
    buffer_load_dwordx4 v45, s[20:23], 0 offen lds
    s_add_u32 m0, m0, 1024
    v_and_or_b32 v46, v46, s46, v102
    buffer_load_dwordx4 v46, s[20:23], 0 offen lds
    s_add_u32 m0, m0, 1024
    v_and_or_b32 v47, v47, s46, v102
    buffer_load_dwordx4 v47, s[20:23], 0 offen lds
    s_branch B_go
A_full:
    s_wqm_b64 exec, vcc
    v_mov_b32 v40, 4194302
    v_mov_b32 v41, 4194303
    v_mov_b32 v42, 4194303
    v_mov_b32 v43, 4194303
    s_mov_b64 exec, -1
    s_branch A_pub
Z_givea:
    ds_write_b32 v5, v4 offset:1124
    v_mov_b32 v112, 4194303
    v_mov_b32 v113, 4194303
    v_mov_b32 v114, 4194303
    v_mov_b32 v115, 4194303
    v_lshrrev_b32 v104, 2, v0
    v_lshrrev_b32 v105, 5, v104
    v_lshlrev_b32 v105, 2, v105
    v_lshlrev_b32 v104, v104, 1
    ds_or_b32 v105, v104 offset:1088
    s_mov_b64 s[88:89], 0
    s_mov_b32 s96, 0
    s_branch Z_nra
Z_fulla:
    s_mov_b64 exec, vcc
    v_mov_b32 v112, 4194303
    v_mov_b32 v113, 4194303
    v_mov_b32 v114, 4194303
    v_mov_b32 v115, 4194303
    v_lshrrev_b32 v104, 2, v0
    v_lshrrev_b32 v105, 5, v104
    v_lshlrev_b32 v105, 2, v105
    v_lshlrev_b32 v104, v104, 1
    ds_or_b32 v105, v104 offset:1088
    s_branch Z_ranka
Z_giveb:
    ds_write_b32 v5, v4 offset:1124
    v_mov_b32 v112, 4194303
    v_mov_b32 v113, 4194303
    v_mov_b32 v114, 4194303
    v_mov_b32 v115, 4194303
    v_lshrrev_b32 v104, 2, v0
    v_lshrrev_b32 v105, 5, v104
    v_lshlrev_b32 v105, 2, v105
    v_lshlrev_b32 v104, v104, 1
    ds_or_b32 v105, v104 offset:1088
    s_mov_b64 s[88:89], 0
    s_mov_b32 s96, 0
    s_branch Z_nrb
Z_fullb:
    s_mov_b64 exec, vcc
    v_mov_b32 v112, 4194303
    v_mov_b32 v113, 4194303
    v_mov_b32 v114, 4194303
    v_mov_b32 v115, 4194303
    v_lshrrev_b32 v104, 2, v0
    v_lshrrev_b32 v105, 5, v104
    v_lshlrev_b32 v105, 2, v105
    v_lshlrev_b32 v104, v104, 1
    ds_or_b32 v105, v104 offset:1088
    s_branch Z_rankb
Y_lost:
    s_wqm_b64 exec, exec
    s_andn2_b64 s[60:61], s[60:61], exec
    ds_write_b32 v5, v4 offset:1132
    v_mov_b32 v116, 4194303
    v_mov_b32 v117, 4194303
    v_mov_b32 v118, 4194303
    v_mov_b32 v119, 4194303
    v_mov_b32 v112, 4194303
    v_mov_b32 v113, 4194303
    v_mov_b32 v114, 4194303
    v_mov_b32 v115, 4194303
    v_lshrrev_b32 v104, 2, v0
    v_lshrrev_b32 v105, 5, v104
    v_lshlrev_b32 v105, 2, v105
    v_lshlrev_b32 v104, v104, 1
    ds_or_b32 v105, v104 offset:1088
    s_mov_b64 s[90:91], 0
    s_mov_b32 s96, 0
    s_branch Y_nr
C_slowcnt:
    s_cmp_lg_u32 s55, 0
    s_cbranch_scc1 C_careful
    v_readlane_b32 s60, v105, 16
    v_readlane_b32 s61, v105, 17
    v_readlane_b32 s62, v105, 18
    v_readlane_b32 s63, v105, 19
    v_readlane_b32 s64, v105, 20
    v_readlane_b32 s65, v105, 21
    v_readlane_b32 s66, v105, 22
    v_readlane_b32 s67, v105, 23
    v_readlane_b32 s3, v105, 25
    s_mov_b32 s55, 2
    s_cmp_lg_u32 s85, 0
    s_cbranch_scc1 C_redo
    s_bitcmp1_b32 s84, 27
    s_cbranch_scc1 C_redo
    s_mov_b32 s55, 1
    s_branch B_cntok
C_redo:
    v_mov_b32 v24, 0
    v_mov_b32 v25, 0
    v_mov_b32 v26, 0
    v_mov_b32 v27, 0
    v_mov_b32 v28, 0
    v_mov_b32 v29, 0
    v_mov_b32 v30, 0
    v_mov_b32 v31, 0
    v_mov_b32 v32, 0
    v_mov_b32 v33, 0
    v_mov_b32 v34, 0
    v_mov_b32 v35, 0
    v_mov_b32 v36, 0
    v_mov_b32 v37, 0
    v_mov_b32 v38, 0
    v_mov_b32 v39, 0
    s_branch C_next
C_careful:
    s_min_u32 s48, s48, 1408
    s_bitcmp1_b32 s84, 24
    s_cselect_b32 s55, 2, 1
    s_branch B_cntok
C_next:
    s_setprio 0
    s_mov_b32 s35, 0
    s_waitcnt vmcnt(0) lgkmcnt(0)
    s_barrier
    s_cmp_eq_u32 s55, 2
    s_cbranch_scc1 C_round
    s_mov_b32 s84, -1
    s_ff1_i32_b32 s85, s67
    s_add_u32 s85, s85, 224
    s_cmp_lg_u32 s67, 0
    s_cselect_b32 s84, s85, s84
    s_ff1_i32_b32 s85, s66
    s_add_u32 s85, s85, 192
    s_cmp_lg_u32 s66, 0
    s_cselect_b32 s84, s85, s84
    s_ff1_i32_b32 s85, s65
    s_add_u32 s85, s85, 160
    s_cmp_lg_u32 s65, 0
    s_cselect_b32 s84, s85, s84
    s_ff1_i32_b32 s85, s64
    s_add_u32 s85, s85, 128
    s_cmp_lg_u32 s64, 0
    s_cselect_b32 s84, s85, s84
    s_ff1_i32_b32 s85, s63
    s_add_u32 s85, s85, 96
    s_cmp_lg_u32 s63, 0
    s_cselect_b32 s84, s85, s84
    s_ff1_i32_b32 s85, s62
    s_add_u32 s85, s85, 64
    s_cmp_lg_u32 s62, 0
    s_cselect_b32 s84, s85, s84
    s_ff1_i32_b32 s85, s61
    s_add_u32 s85, s85, 32
    s_cmp_lg_u32 s61, 0
    s_cselect_b32 s84, s85, s84
    s_ff1_i32_b32 s85, s60
    s_add_u32 s85, s85, 0
    s_cmp_lg_u32 s60, 0
    s_cselect_b32 s84, s85, s84
    s_cmp_eq_u32 s84, -1
    s_cbranch_scc1 B_epi
    s_lshr_b32 s85, s84, 5
    s_lshl_b32 s86, 1, s84
    s_andn2_b32 s87, s60, s86
    s_cmp_eq_u32 s85, 0
    s_cselect_b32 s60, s87, s60
    s_andn2_b32 s87, s61, s86
    s_cmp_eq_u32 s85, 1
    s_cselect_b32 s61, s87, s61
    s_andn2_b32 s87, s62, s86
    s_cmp_eq_u32 s85, 2
    s_cselect_b32 s62, s87, s62
    s_andn2_b32 s87, s63, s86
    s_cmp_eq_u32 s85, 3
    s_cselect_b32 s63, s87, s63
    s_andn2_b32 s87, s64, s86
    s_cmp_eq_u32 s85, 4
    s_cselect_b32 s64, s87, s64
    s_andn2_b32 s87, s65, s86
    s_cmp_eq_u32 s85, 5
    s_cselect_b32 s65, s87, s65
    s_andn2_b32 s87, s66, s86
    s_cmp_eq_u32 s85, 6
    s_cselect_b32 s66, s87, s66
    s_andn2_b32 s87, s67, s86
    s_cmp_eq_u32 s85, 7
    s_cselect_b32 s67, s87, s67
    s_mul_i32 s84, s84, 12500
    buffer_load_dword v40, v2, s[28:31], s84 offen
    buffer_load_dword v44, v2, s[24:27], s84 offen
    s_add_u32 s84, s84, 4096
    buffer_load_dword v41, v2, s[28:31], s84 offen
    buffer_load_dword v45, v2, s[24:27], s84 offen
    s_add_u32 s84, s84, 4096
    buffer_load_dword v42, v2, s[28:31], s84 offen
    buffer_load_dword v46, v2, s[24:27], s84 offen
    s_add_u32 s84, s84, 4096
    buffer_load_dword v43, v2, s[28:31], s84 offen
    buffer_load_dword v47, v2, s[24:27], s84 offen
    s_add_u32 s84, s84, 4096
    v_mov_b32 v116, 4194303
    v_mov_b32 v117, 4194303
    v_mov_b32 v118, 4194303
    v_mov_b32 v119, 4194303
    v_mov_b32 v105, 4194303
    s_waitcnt vmcnt(0)
    v_mov_b32 v104, v40
    v_and_b32 v104, 255, v104
    v_cmp_eq_u32 vcc, s2, v104
    v_lshrrev_b32 v40, 8, v40
    v_lshl_or_b32 v44, v44, 7, v40
    v_cndmask_b32 v112, v105, v44, vcc
    v_mov_b32 v104, v41
    v_and_b32 v104, 255, v104
    v_cmp_eq_u32 vcc, s2, v104
    v_lshrrev_b32 v41, 8, v41
    v_lshl_or_b32 v45, v45, 7, v41
    v_cndmask_b32 v113, v105, v45, vcc
    v_mov_b32 v104, v42
    v_and_b32 v104, 255, v104
    v_cmp_eq_u32 vcc, s2, v104
    v_lshrrev_b32 v42, 8, v42
    v_lshl_or_b32 v46, v46, 7, v42
    v_cndmask_b32 v114, v105, v46, vcc
    v_mov_b32 v104, v43
    v_and_b32 v104, 255, v104
    v_cmp_eq_u32 vcc, s2, v104
    v_lshrrev_b32 v43, 8, v43
    v_lshl_or_b32 v47, v47, 7, v43
    s_and_b64 vcc, vcc, s[58:59]
    v_cndmask_b32 v115, v105, v47, vcc
C_round:
    v_mov_b32 v108, 4194303
    v_mov_b32 v109, 4194303
    v_mov_b32 v110, 4194303
    v_mov_b32 v111, 4194303
    v_add_u32 v104, 141312, v3
    ds_write_b128 v104, v[108:111]
    s_cmp_ge_u32 s44, 6
    s_cbranch_scc1 C_i1
    ds_write_b128 v104, v[108:111] offset:16384
C_i1:
    s_cmp_lg_u32 s44, 12
    s_cbranch_scc1 C_i2
    s_mov_b64 exec, 0xffff
    ds_write_b32 v124, v126 offset:1024
    ds_write_b32 v5, v5 offset:1120
    s_mov_b64 exec, -1
C_i2:
    s_waitcnt lgkmcnt(0)
    s_barrier
    s_mov_b32 s88, 352
    s_mov_b32 s89, 142720
    v_cmp_ne_u32 s[68:69], s54, v112
    v_and_b32 v40, 15, v112
    v_lshlrev_b32 v40, 2, v40
    s_mov_b64 exec, s[68:69]
    ds_add_rtn_u32 v48, v40, v4 offset:1024
    s_mov_b64 exec, -1
    v_mul_u32_u24 v107, s88, v40
    v_add_u32 v107, s89, v107
    s_mov_b64 exec, s[68:69]
    s_waitcnt lgkmcnt(0)
    v_cmp_lt_u32 vcc, v48, v107
    s_and_saveexec_b64 s[90:91], vcc
    ds_write_b32 v48, v112
    v_mov_b32 v112, 4194303
    s_andn2_b64 exec, s[90:91], exec
    ds_write_b32 v5, v4 offset:1120
    s_mov_b64 exec, -1
    v_cmp_ne_u32 s[70:71], s54, v113
    v_and_b32 v41, 15, v113
    v_lshlrev_b32 v41, 2, v41
    s_mov_b64 exec, s[70:71]
    ds_add_rtn_u32 v49, v41, v4 offset:1024
    s_mov_b64 exec, -1
    v_mul_u32_u24 v107, s88, v41
    v_add_u32 v107, s89, v107
    s_mov_b64 exec, s[70:71]
    s_waitcnt lgkmcnt(0)
    v_cmp_lt_u32 vcc, v49, v107
    s_and_saveexec_b64 s[90:91], vcc
    ds_write_b32 v49, v113
    v_mov_b32 v113, 4194303
    s_andn2_b64 exec, s[90:91], exec
    ds_write_b32 v5, v4 offset:1120
    s_mov_b64 exec, -1
    v_cmp_ne_u32 s[72:73], s54, v114
    v_and_b32 v42, 15, v114
    v_lshlrev_b32 v42, 2, v42
    s_mov_b64 exec, s[72:73]
    ds_add_rtn_u32 v50, v42, v4 offset:1024
    s_mov_b64 exec, -1
    v_mul_u32_u24 v107, s88, v42
    v_add_u32 v107, s89, v107
    s_mov_b64 exec, s[72:73]
    s_waitcnt lgkmcnt(0)
    v_cmp_lt_u32 vcc, v50, v107
    s_and_saveexec_b64 s[90:91], vcc
    ds_write_b32 v50, v114
    v_mov_b32 v114, 4194303
    s_andn2_b64 exec, s[90:91], exec
    ds_write_b32 v5, v4 offset:1120
    s_mov_b64 exec, -1
    v_cmp_ne_u32 s[74:75], s54, v115
    v_and_b32 v43, 15, v115
    v_lshlrev_b32 v43, 2, v43
    s_mov_b64 exec, s[74:75]
    ds_add_rtn_u32 v51, v43, v4 offset:1024
    s_mov_b64 exec, -1
    v_mul_u32_u24 v107, s88, v43
    v_add_u32 v107, s89, v107
    s_mov_b64 exec, s[74:75]
    s_waitcnt lgkmcnt(0)
    v_cmp_lt_u32 vcc, v51, v107
    s_and_saveexec_b64 s[90:91], vcc
    ds_write_b32 v51, v115
    v_mov_b32 v115, 4194303
    s_andn2_b64 exec, s[90:91], exec
    ds_write_b32 v5, v4 offset:1120
    s_mov_b64 exec, -1
    v_cmp_ne_u32 s[76:77], s54, v116
    v_and_b32 v44, 15, v116
    v_lshlrev_b32 v44, 2, v44
    s_mov_b64 exec, s[76:77]
    ds_add_rtn_u32 v52, v44, v4 offset:1024
    s_mov_b64 exec, -1
    v_mul_u32_u24 v107, s88, v44
    v_add_u32 v107, s89, v107
    s_mov_b64 exec, s[76:77]
    s_waitcnt lgkmcnt(0)
    v_cmp_lt_u32 vcc, v52, v107
    s_and_saveexec_b64 s[90:91], vcc
    ds_write_b32 v52, v116
    v_mov_b32 v116, 4194303
    s_andn2_b64 exec, s[90:91], exec
    ds_write_b32 v5, v4 offset:1120
    s_mov_b64 exec, -1
    v_cmp_ne_u32 s[78:79], s54, v117
    v_and_b32 v45, 15, v117
    v_lshlrev_b32 v45, 2, v45
    s_mov_b64 exec, s[78:79]
    ds_add_rtn_u32 v53, v45, v4 offset:1024
    s_mov_b64 exec, -1
    v_mul_u32_u24 v107, s88, v45
    v_add_u32 v107, s89, v107
    s_mov_b64 exec, s[78:79]
    s_waitcnt lgkmcnt(0)
    v_cmp_lt_u32 vcc, v53, v107
    s_and_saveexec_b64 s[90:91], vcc
    ds_write_b32 v53, v117
    v_mov_b32 v117, 4194303
    s_andn2_b64 exec, s[90:91], exec
    ds_write_b32 v5, v4 offset:1120
    s_mov_b64 exec, -1
    v_cmp_ne_u32 s[80:81], s54, v118
    v_and_b32 v46, 15, v118
    v_lshlrev_b32 v46, 2, v46
    s_mov_b64 exec, s[80:81]
    ds_add_rtn_u32 v54, v46, v4 offset:1024
    s_mov_b64 exec, -1
    v_mul_u32_u24 v107, s88, v46
    v_add_u32 v107, s89, v107
    s_mov_b64 exec, s[80:81]
    s_waitcnt lgkmcnt(0)
    v_cmp_lt_u32 vcc, v54, v107
    s_and_saveexec_b64 s[90:91], vcc
    ds_write_b32 v54, v118
    v_mov_b32 v118, 4194303
    s_andn2_b64 exec, s[90:91], exec
    ds_write_b32 v5, v4 offset:1120
    s_mov_b64 exec, -1
    v_cmp_ne_u32 s[82:83], s54, v119
    v_and_b32 v47, 15, v119
    v_lshlrev_b32 v47, 2, v47
    s_mov_b64 exec, s[82:83]
    ds_add_rtn_u32 v55, v47, v4 offset:1024
    s_mov_b64 exec, -1
    v_mul_u32_u24 v107, s88, v47
    v_add_u32 v107, s89, v107
    s_mov_b64 exec, s[82:83]
    s_waitcnt lgkmcnt(0)
    v_cmp_lt_u32 vcc, v55, v107
    s_and_saveexec_b64 s[90:91], vcc
    ds_write_b32 v55, v119
    v_mov_b32 v119, 4194303
    s_andn2_b64 exec, s[90:91], exec
    ds_write_b32 v5, v4 offset:1120
    s_mov_b64 exec, -1
    v_mov_b32 v100, v103
    v_mov_b32 v101, v120
    s_waitcnt lgkmcnt(0)
    s_barrier
L_last:
    s_branch B_counts
.section .rodata,"a"
.p2align 6
.amdhsa_kernel standalone__kernel_systems_refs_featgraph__graph_kernel
  .amdhsa_next_free_vgpr 128
  .amdhsa_next_free_sgpr 102
  .amdhsa_accum_offset 128
  .amdhsa_group_segment_fixed_size 0
  .amdhsa_kernarg_size 64
  .amdhsa_user_sgpr_count 2
  .amdhsa_user_sgpr_kernarg_segment_ptr 1
  .amdhsa_system_sgpr_workgroup_id_x 1
.end_amdhsa_kernel
```
